```python
import torch

def _softmax(x, axis=-1):
    return torch.softmax(x, dim=axis)
def _gelu(x):
    return torch.nn.functional.gelu(x, approximate="tanh")
def _silu(x):
    return torch.nn.functional.silu(x)
def _sigmoid(x):
    return torch.sigmoid(x)
def _layernorm(x, axis=-1, eps=1e-5):
    m = x.mean(dim=axis, keepdim=True)
    v = x.var(dim=axis, keepdim=True, unbiased=False)
    return (x - m) / torch.sqrt(v + eps)
def _scatter_add(tgt, idx, src, axis=0):
    return tgt.clone().index_add_(axis, idx, src)
def _segment_sum(src, seg, n):
    out = torch.zeros((n,) + src.shape[1:], dtype=src.dtype)
    return out.index_add_(0, seg, src)
def _pad(x, pw):
    flat = tuple(v for pair in reversed(pw) for v in pair)
    return torch.nn.functional.pad(x, flat)

kernel_name = 'standalone__gqa_softmax__sampling'

def setup_inputs():

    _w = (lambda a: (lambda t: t.to(torch.bfloat16) if t.is_floating_point() else t)(torch.as_tensor(a)))
    B, Hq, Hkv, Sq, Sk, D = 16, 32, 16, 4, 4096, 128
    return {
        "q": _w((lambda *s: torch.randn(*s, dtype=torch.bfloat16) * 0.8)(B, Hq, Sq, D)),
        "k": _w((lambda *s: torch.randn(*s, dtype=torch.bfloat16) * 0.8)(B, Hkv, Sk, D)),
        "v": _w((lambda *s: torch.randn(*s, dtype=torch.bfloat16) * 0.05)(B, Hkv, Sk, D)),
    }

def reference(q, k, v):
    B, Hq, Sq, D = q.shape
    Hkv = k.shape[1]
    rep = Hq // Hkv
    k = (lambda x, n, axis: torch.repeat_interleave(x, n, dim=axis))(k, rep, axis=1)
    v = (lambda x, n, axis: torch.repeat_interleave(x, n, dim=axis))(v, rep, axis=1)
    scale = D ** -0.5
    scores = torch.einsum("bhqd,bhkd->bhqk", q, k) * scale
    p = _softmax(scores, axis=-1)
    return torch.einsum("bhqk,bhkd->bhqd", p, v)
```

```asm
; @launch grid=(256,1,1) block=(384,1,1) lds=100416
.amdgcn_target "amdgcn-amd-amdhsa--gfx950"
.text
.globl standalone__gqa_softmax__sampling_kernel
.p2align 8
.type standalone__gqa_softmax__sampling_kernel,@function
standalone__gqa_softmax__sampling_kernel:
  s_load_dwordx4 s[4:7], s[0:1], 8
  v_lshrrev_b32 v1, 6, v0
  s_lshr_b32 s3, s2, 8
  s_cbranch_scc1 L_end
  v_readfirstlane_b32 s3, v1
  v_bfe_u32 v2, v0, 4, 2
  v_and_b32 v3, 15, v0
  s_lshr_b32 s39, s2, 3
  s_cmp_lg_u32 s3, 0
  s_cbranch_scc1 L_consumer
  v_xor_b32 v4, v2, v3
  v_lshlrev_b32 v4, 4, v4
  v_lshl_add_u32 v8, v2, 8, v4
  v_xor_b32 v9, 0x40, v8
  v_xor_b32 v10, 0x1880, v8
  v_xor_b32 v11, 0x18c0, v8
  s_bfe_u32 s29, s2, 0x30003
  s_lshl_b32 s29, s29, 17
  s_lshl_b32 s20, s2, 20
  s_lshl_b32 s10, 1, 20
  s_lshl_b32 s11, 1, 17
  s_mov_b32 m0, 0
  s_mov_b32 s23, s29
  s_mov_b32 s28, 0
  s_mov_b32 s22, s29
  s_mov_b32 s31, 98304
  v_mov_b32 v16, 100352
  v_mov_b32 v17, 2
  ds_write_b32 v16, v17
  s_waitcnt lgkmcnt(0)
  s_add_u32 s8, s4, s20
  s_addc_u32 s9, s5, 0
L_load_loop:
  s_waitcnt vmcnt(19)
  buffer_load_dwordx4 v8, s[8:11], s23 offen offset:0 nt lds
  s_waitcnt vmcnt(19)
  buffer_load_dwordx4 v9, s[8:11], s23 offen offset:1024 nt lds
  s_waitcnt vmcnt(19)
  buffer_load_dwordx4 v10, s[8:11], s23 offen offset:2048 nt lds
  s_waitcnt vmcnt(19)
  buffer_load_dwordx4 v11, s[8:11], s23 offen offset:3072 nt lds
  s_addk_i32 m0, 0x1000
  s_xor_b32 s23, s22, 0x8000
  s_waitcnt vmcnt(19)
  buffer_load_dwordx4 v8, s[8:11], s23 offen offset:0 nt lds
  s_waitcnt vmcnt(19)
  buffer_load_dwordx4 v9, s[8:11], s23 offen offset:1024 nt lds
  s_waitcnt vmcnt(19)
  buffer_load_dwordx4 v10, s[8:11], s23 offen offset:2048 nt lds
  s_waitcnt vmcnt(19)
  buffer_load_dwordx4 v11, s[8:11], s23 offen offset:3072 nt lds
  s_addk_i32 m0, 0x1000
  s_xor_b32 s23, s22, 0x800
  s_waitcnt vmcnt(19)
  buffer_load_dwordx4 v8, s[8:11], s23 offen offset:0 nt lds
  s_waitcnt vmcnt(19)
  buffer_load_dwordx4 v9, s[8:11], s23 offen offset:1024 nt lds
  s_waitcnt vmcnt(19)
  buffer_load_dwordx4 v10, s[8:11], s23 offen offset:2048 nt lds
  s_waitcnt vmcnt(19)
  buffer_load_dwordx4 v11, s[8:11], s23 offen offset:3072 nt lds
  s_addk_i32 m0, 0x1000
  s_xor_b32 s23, s22, 0x8800
  s_waitcnt vmcnt(19)
  buffer_load_dwordx4 v8, s[8:11], s23 offen offset:0 nt lds
  s_waitcnt vmcnt(19)
  buffer_load_dwordx4 v9, s[8:11], s23 offen offset:1024 nt lds
  s_waitcnt vmcnt(19)
  buffer_load_dwordx4 v10, s[8:11], s23 offen offset:2048 nt lds
  s_waitcnt vmcnt(19)
  buffer_load_dwordx4 v11, s[8:11], s23 offen offset:3072 nt lds
  s_addk_i32 m0, 0x1000
  s_xor_b32 s23, s22, 0x4000
  s_waitcnt vmcnt(19)
  buffer_load_dwordx4 v8, s[8:11], s23 offen offset:0 nt lds
  s_waitcnt vmcnt(19)
  buffer_load_dwordx4 v9, s[8:11], s23 offen offset:1024 nt lds
  s_waitcnt vmcnt(19)
  buffer_load_dwordx4 v10, s[8:11], s23 offen offset:2048 nt lds
  s_waitcnt vmcnt(19)
  buffer_load_dwordx4 v11, s[8:11], s23 offen offset:3072 nt lds
  s_addk_i32 m0, 0x1000
  s_xor_b32 s23, s22, 0xc000
  s_waitcnt vmcnt(19)
  buffer_load_dwordx4 v8, s[8:11], s23 offen offset:0 nt lds
  ds_read_b32 v17, v16
  s_waitcnt vmcnt(19)
  buffer_load_dwordx4 v9, s[8:11], s23 offen offset:1024 nt lds
  s_waitcnt vmcnt(19)
  buffer_load_dwordx4 v10, s[8:11], s23 offen offset:2048 nt lds
  s_cmp_eq_u32 s28, 0
  s_waitcnt vmcnt(19)
  buffer_load_dwordx4 v11, s[8:11], s23 offen offset:3072 nt lds
  s_cbranch_scc1 L_load_nobar2
  s_barrier
L_load_nobar2:
  s_addk_i32 m0, 0x1000
  s_xor_b32 s23, s22, 0x4800
  s_waitcnt vmcnt(19)
  buffer_load_dwordx4 v8, s[8:11], s23 offen offset:0 nt lds
  s_waitcnt vmcnt(19)
  buffer_load_dwordx4 v9, s[8:11], s23 offen offset:1024 nt lds
  s_add_u32 s24, m0, 0x2000
  s_cmp_eq_u32 s24, s31
  s_cselect_b32 s24, 0, s24
  s_waitcnt vmcnt(19)
  buffer_load_dwordx4 v10, s[8:11], s23 offen offset:2048 nt lds
  s_add_u32 s28, s28, 1
  s_waitcnt lgkmcnt(0)
  v_readfirstlane_b32 s37, v17
  s_waitcnt vmcnt(19)
  buffer_load_dwordx4 v11, s[8:11], s23 offen offset:3072 nt lds
  s_addk_i32 m0, 0x1000
  s_xor_b32 s23, s22, 0xc800
  s_waitcnt vmcnt(19)
  buffer_load_dwordx4 v8, s[8:11], s23 offen offset:0 nt lds
  s_bfe_u32 s21, s28, 0x40000
  s_lshl_b32 s21, s21, 16
  s_xor_b32 s22, s21, s29
  s_waitcnt vmcnt(19)
  buffer_load_dwordx4 v9, s[8:11], s23 offen offset:1024 nt lds
  s_bfe_u32 s21, s28, 0x10004
  s_lshl_b32 s21, s21, 12
  s_xor_b32 s22, s21, s22
  s_waitcnt vmcnt(19)
  buffer_load_dwordx4 v10, s[8:11], s23 offen offset:2048 nt lds
  s_and_b32 s21, s28, 31
  s_cselect_b32 s37, s37, 5
  s_waitcnt vmcnt(19)
  buffer_load_dwordx4 v11, s[8:11], s23 offen offset:3072 nt lds
  s_mov_b32 m0, s24
  s_mov_b32 s23, s22
L_load_pick:
  s_cmp_eq_u32 s37, 2
  s_cbranch_scc1 L_load_loop
  s_cmp_eq_u32 s37, 0
  s_cbranch_scc1 L_load_w0
  s_cmp_eq_u32 s37, 1
  s_cbranch_scc1 L_load_w1
  s_cmp_eq_u32 s37, 3
  s_cbranch_scc1 L_load_w3
  s_cmp_eq_u32 s37, 4
  s_cbranch_scc1 L_load_w4
  s_branch L_load_phase
L_load_w0:
  s_waitcnt vmcnt(16)
  buffer_load_dwordx4 v8, s[8:11], s23 offen offset:0 nt lds
  s_waitcnt vmcnt(16)
  buffer_load_dwordx4 v9, s[8:11], s23 offen offset:1024 nt lds
  s_waitcnt vmcnt(16)
  buffer_load_dwordx4 v10, s[8:11], s23 offen offset:2048 nt lds
  s_waitcnt vmcnt(16)
  buffer_load_dwordx4 v11, s[8:11], s23 offen offset:3072 nt lds
  s_addk_i32 m0, 0x1000
  s_xor_b32 s23, s22, 0x8000
  s_waitcnt vmcnt(16)
  buffer_load_dwordx4 v8, s[8:11], s23 offen offset:0 nt lds
  s_waitcnt vmcnt(16)
  buffer_load_dwordx4 v9, s[8:11], s23 offen offset:1024 nt lds
  s_waitcnt vmcnt(16)
  buffer_load_dwordx4 v10, s[8:11], s23 offen offset:2048 nt lds
  s_waitcnt vmcnt(16)
  buffer_load_dwordx4 v11, s[8:11], s23 offen offset:3072 nt lds
  s_addk_i32 m0, 0x1000
  s_xor_b32 s23, s22, 0x800
  s_waitcnt vmcnt(16)
  buffer_load_dwordx4 v8, s[8:11], s23 offen offset:0 nt lds
  s_waitcnt vmcnt(16)
  buffer_load_dwordx4 v9, s[8:11], s23 offen offset:1024 nt lds
  s_waitcnt vmcnt(16)
  buffer_load_dwordx4 v10, s[8:11], s23 offen offset:2048 nt lds
  s_waitcnt vmcnt(16)
  buffer_load_dwordx4 v11, s[8:11], s23 offen offset:3072 nt lds
  s_addk_i32 m0, 0x1000
  s_xor_b32 s23, s22, 0x8800
  s_waitcnt vmcnt(16)
  buffer_load_dwordx4 v8, s[8:11], s23 offen offset:0 nt lds
  s_waitcnt vmcnt(16)
  buffer_load_dwordx4 v9, s[8:11], s23 offen offset:1024 nt lds
  s_waitcnt vmcnt(16)
  buffer_load_dwordx4 v10, s[8:11], s23 offen offset:2048 nt lds
  s_waitcnt vmcnt(16)
  buffer_load_dwordx4 v11, s[8:11], s23 offen offset:3072 nt lds
  s_addk_i32 m0, 0x1000
  s_xor_b32 s23, s22, 0x4000
  s_waitcnt vmcnt(16)
  buffer_load_dwordx4 v8, s[8:11], s23 offen offset:0 nt lds
  s_waitcnt vmcnt(16)
  buffer_load_dwordx4 v9, s[8:11], s23 offen offset:1024 nt lds
  s_waitcnt vmcnt(16)
  buffer_load_dwordx4 v10, s[8:11], s23 offen offset:2048 nt lds
  s_waitcnt vmcnt(16)
  buffer_load_dwordx4 v11, s[8:11], s23 offen offset:3072 nt lds
  s_addk_i32 m0, 0x1000
  s_xor_b32 s23, s22, 0xc000
  s_waitcnt vmcnt(16)
  buffer_load_dwordx4 v8, s[8:11], s23 offen offset:0 nt lds
  ds_read_b32 v17, v16
  s_waitcnt vmcnt(16)
  buffer_load_dwordx4 v9, s[8:11], s23 offen offset:1024 nt lds
  s_waitcnt vmcnt(16)
  buffer_load_dwordx4 v10, s[8:11], s23 offen offset:2048 nt lds
  s_cmp_eq_u32 s28, 0
  s_waitcnt vmcnt(16)
  buffer_load_dwordx4 v11, s[8:11], s23 offen offset:3072 nt lds
  s_cbranch_scc1 L_load_nobar0
  s_barrier
L_load_nobar0:
  s_addk_i32 m0, 0x1000
  s_xor_b32 s23, s22, 0x4800
  s_waitcnt vmcnt(16)
  buffer_load_dwordx4 v8, s[8:11], s23 offen offset:0 nt lds
  s_waitcnt vmcnt(16)
  buffer_load_dwordx4 v9, s[8:11], s23 offen offset:1024 nt lds
  s_add_u32 s24, m0, 0x2000
  s_cmp_eq_u32 s24, s31
  s_cselect_b32 s24, 0, s24
  s_waitcnt vmcnt(16)
  buffer_load_dwordx4 v10, s[8:11], s23 offen offset:2048 nt lds
  s_add_u32 s28, s28, 1
  s_waitcnt lgkmcnt(0)
  v_readfirstlane_b32 s37, v17
  s_waitcnt vmcnt(16)
  buffer_load_dwordx4 v11, s[8:11], s23 offen offset:3072 nt lds
  s_addk_i32 m0, 0x1000
  s_xor_b32 s23, s22, 0xc800
  s_waitcnt vmcnt(16)
  buffer_load_dwordx4 v8, s[8:11], s23 offen offset:0 nt lds
  s_bfe_u32 s21, s28, 0x40000
  s_lshl_b32 s21, s21, 16
  s_xor_b32 s22, s21, s29
  s_waitcnt vmcnt(16)
  buffer_load_dwordx4 v9, s[8:11], s23 offen offset:1024 nt lds
  s_bfe_u32 s21, s28, 0x10004
  s_lshl_b32 s21, s21, 12
  s_xor_b32 s22, s21, s22
  s_waitcnt vmcnt(16)
  buffer_load_dwordx4 v10, s[8:11], s23 offen offset:2048 nt lds
  s_and_b32 s21, s28, 31
  s_cselect_b32 s37, s37, 5
  s_waitcnt vmcnt(16)
  buffer_load_dwordx4 v11, s[8:11], s23 offen offset:3072 nt lds
  s_mov_b32 m0, s24
  s_mov_b32 s23, s22
  s_cmp_eq_u32 s37, 0
  s_cbranch_scc1 L_load_w0
  s_branch L_load_pick
L_load_w1:
  s_waitcnt vmcnt(18)
  buffer_load_dwordx4 v8, s[8:11], s23 offen offset:0 nt lds
  s_waitcnt vmcnt(18)
  buffer_load_dwordx4 v9, s[8:11], s23 offen offset:1024 nt lds
  s_waitcnt vmcnt(18)
  buffer_load_dwordx4 v10, s[8:11], s23 offen offset:2048 nt lds
  s_waitcnt vmcnt(18)
  buffer_load_dwordx4 v11, s[8:11], s23 offen offset:3072 nt lds
  s_addk_i32 m0, 0x1000
  s_xor_b32 s23, s22, 0x8000
  s_waitcnt vmcnt(18)
  buffer_load_dwordx4 v8, s[8:11], s23 offen offset:0 nt lds
  s_waitcnt vmcnt(18)
  buffer_load_dwordx4 v9, s[8:11], s23 offen offset:1024 nt lds
  s_waitcnt vmcnt(18)
  buffer_load_dwordx4 v10, s[8:11], s23 offen offset:2048 nt lds
  s_waitcnt vmcnt(18)
  buffer_load_dwordx4 v11, s[8:11], s23 offen offset:3072 nt lds
  s_addk_i32 m0, 0x1000
  s_xor_b32 s23, s22, 0x800
  s_waitcnt vmcnt(18)
  buffer_load_dwordx4 v8, s[8:11], s23 offen offset:0 nt lds
  s_waitcnt vmcnt(18)
  buffer_load_dwordx4 v9, s[8:11], s23 offen offset:1024 nt lds
  s_waitcnt vmcnt(18)
  buffer_load_dwordx4 v10, s[8:11], s23 offen offset:2048 nt lds
  s_waitcnt vmcnt(18)
  buffer_load_dwordx4 v11, s[8:11], s23 offen offset:3072 nt lds
  s_addk_i32 m0, 0x1000
  s_xor_b32 s23, s22, 0x8800
  s_waitcnt vmcnt(18)
  buffer_load_dwordx4 v8, s[8:11], s23 offen offset:0 nt lds
  s_waitcnt vmcnt(18)
  buffer_load_dwordx4 v9, s[8:11], s23 offen offset:1024 nt lds
  s_waitcnt vmcnt(18)
  buffer_load_dwordx4 v10, s[8:11], s23 offen offset:2048 nt lds
  s_waitcnt vmcnt(18)
  buffer_load_dwordx4 v11, s[8:11], s23 offen offset:3072 nt lds
  s_addk_i32 m0, 0x1000
  s_xor_b32 s23, s22, 0x4000
  s_waitcnt vmcnt(18)
  buffer_load_dwordx4 v8, s[8:11], s23 offen offset:0 nt lds
  s_waitcnt vmcnt(18)
  buffer_load_dwordx4 v9, s[8:11], s23 offen offset:1024 nt lds
  s_waitcnt vmcnt(18)
  buffer_load_dwordx4 v10, s[8:11], s23 offen offset:2048 nt lds
  s_waitcnt vmcnt(18)
  buffer_load_dwordx4 v11, s[8:11], s23 offen offset:3072 nt lds
  s_addk_i32 m0, 0x1000
  s_xor_b32 s23, s22, 0xc000
  s_waitcnt vmcnt(18)
  buffer_load_dwordx4 v8, s[8:11], s23 offen offset:0 nt lds
  ds_read_b32 v17, v16
  s_waitcnt vmcnt(18)
  buffer_load_dwordx4 v9, s[8:11], s23 offen offset:1024 nt lds
  s_waitcnt vmcnt(18)
  buffer_load_dwordx4 v10, s[8:11], s23 offen offset:2048 nt lds
  s_cmp_eq_u32 s28, 0
  s_waitcnt vmcnt(18)
  buffer_load_dwordx4 v11, s[8:11], s23 offen offset:3072 nt lds
  s_cbranch_scc1 L_load_nobar1
  s_barrier
L_load_nobar1:
  s_addk_i32 m0, 0x1000
  s_xor_b32 s23, s22, 0x4800
  s_waitcnt vmcnt(18)
  buffer_load_dwordx4 v8, s[8:11], s23 offen offset:0 nt lds
  s_waitcnt vmcnt(18)
  buffer_load_dwordx4 v9, s[8:11], s23 offen offset:1024 nt lds
  s_add_u32 s24, m0, 0x2000
  s_cmp_eq_u32 s24, s31
  s_cselect_b32 s24, 0, s24
  s_waitcnt vmcnt(18)
  buffer_load_dwordx4 v10, s[8:11], s23 offen offset:2048 nt lds
  s_add_u32 s28, s28, 1
  s_waitcnt lgkmcnt(0)
  v_readfirstlane_b32 s37, v17
  s_waitcnt vmcnt(18)
  buffer_load_dwordx4 v11, s[8:11], s23 offen offset:3072 nt lds
  s_addk_i32 m0, 0x1000
  s_xor_b32 s23, s22, 0xc800
  s_waitcnt vmcnt(18)
  buffer_load_dwordx4 v8, s[8:11], s23 offen offset:0 nt lds
  s_bfe_u32 s21, s28, 0x40000
  s_lshl_b32 s21, s21, 16
  s_xor_b32 s22, s21, s29
  s_waitcnt vmcnt(18)
  buffer_load_dwordx4 v9, s[8:11], s23 offen offset:1024 nt lds
  s_bfe_u32 s21, s28, 0x10004
  s_lshl_b32 s21, s21, 12
  s_xor_b32 s22, s21, s22
  s_waitcnt vmcnt(18)
  buffer_load_dwordx4 v10, s[8:11], s23 offen offset:2048 nt lds
  s_and_b32 s21, s28, 31
  s_cselect_b32 s37, s37, 5
  s_waitcnt vmcnt(18)
  buffer_load_dwordx4 v11, s[8:11], s23 offen offset:3072 nt lds
  s_mov_b32 m0, s24
  s_mov_b32 s23, s22
  s_cmp_eq_u32 s37, 1
  s_cbranch_scc1 L_load_w1
  s_branch L_load_pick
L_load_w3:
  s_waitcnt vmcnt(20)
  buffer_load_dwordx4 v8, s[8:11], s23 offen offset:0 nt lds
  s_waitcnt vmcnt(20)
  buffer_load_dwordx4 v9, s[8:11], s23 offen offset:1024 nt lds
  s_waitcnt vmcnt(20)
  buffer_load_dwordx4 v10, s[8:11], s23 offen offset:2048 nt lds
  s_waitcnt vmcnt(20)
  buffer_load_dwordx4 v11, s[8:11], s23 offen offset:3072 nt lds
  s_addk_i32 m0, 0x1000
  s_xor_b32 s23, s22, 0x8000
  s_waitcnt vmcnt(20)
  buffer_load_dwordx4 v8, s[8:11], s23 offen offset:0 nt lds
  s_waitcnt vmcnt(20)
  buffer_load_dwordx4 v9, s[8:11], s23 offen offset:1024 nt lds
  s_waitcnt vmcnt(20)
  buffer_load_dwordx4 v10, s[8:11], s23 offen offset:2048 nt lds
  s_waitcnt vmcnt(20)
  buffer_load_dwordx4 v11, s[8:11], s23 offen offset:3072 nt lds
  s_addk_i32 m0, 0x1000
  s_xor_b32 s23, s22, 0x800
  s_waitcnt vmcnt(20)
  buffer_load_dwordx4 v8, s[8:11], s23 offen offset:0 nt lds
  s_waitcnt vmcnt(20)
  buffer_load_dwordx4 v9, s[8:11], s23 offen offset:1024 nt lds
  s_waitcnt vmcnt(20)
  buffer_load_dwordx4 v10, s[8:11], s23 offen offset:2048 nt lds
  s_waitcnt vmcnt(20)
  buffer_load_dwordx4 v11, s[8:11], s23 offen offset:3072 nt lds
  s_addk_i32 m0, 0x1000
  s_xor_b32 s23, s22, 0x8800
  s_waitcnt vmcnt(20)
  buffer_load_dwordx4 v8, s[8:11], s23 offen offset:0 nt lds
  s_waitcnt vmcnt(20)
  buffer_load_dwordx4 v9, s[8:11], s23 offen offset:1024 nt lds
  s_waitcnt vmcnt(20)
  buffer_load_dwordx4 v10, s[8:11], s23 offen offset:2048 nt lds
  s_waitcnt vmcnt(20)
  buffer_load_dwordx4 v11, s[8:11], s23 offen offset:3072 nt lds
  s_addk_i32 m0, 0x1000
  s_xor_b32 s23, s22, 0x4000
  s_waitcnt vmcnt(20)
  buffer_load_dwordx4 v8, s[8:11], s23 offen offset:0 nt lds
  s_waitcnt vmcnt(20)
  buffer_load_dwordx4 v9, s[8:11], s23 offen offset:1024 nt lds
  s_waitcnt vmcnt(20)
  buffer_load_dwordx4 v10, s[8:11], s23 offen offset:2048 nt lds
  s_waitcnt vmcnt(20)
  buffer_load_dwordx4 v11, s[8:11], s23 offen offset:3072 nt lds
  s_addk_i32 m0, 0x1000
  s_xor_b32 s23, s22, 0xc000
  s_waitcnt vmcnt(20)
  buffer_load_dwordx4 v8, s[8:11], s23 offen offset:0 nt lds
  ds_read_b32 v17, v16
  s_waitcnt vmcnt(20)
  buffer_load_dwordx4 v9, s[8:11], s23 offen offset:1024 nt lds
  s_waitcnt vmcnt(20)
  buffer_load_dwordx4 v10, s[8:11], s23 offen offset:2048 nt lds
  s_cmp_eq_u32 s28, 0
  s_waitcnt vmcnt(20)
  buffer_load_dwordx4 v11, s[8:11], s23 offen offset:3072 nt lds
  s_cbranch_scc1 L_load_nobar3
  s_barrier
L_load_nobar3:
  s_addk_i32 m0, 0x1000
  s_xor_b32 s23, s22, 0x4800
  s_waitcnt vmcnt(20)
  buffer_load_dwordx4 v8, s[8:11], s23 offen offset:0 nt lds
  s_waitcnt vmcnt(20)
  buffer_load_dwordx4 v9, s[8:11], s23 offen offset:1024 nt lds
  s_add_u32 s24, m0, 0x2000
  s_cmp_eq_u32 s24, s31
  s_cselect_b32 s24, 0, s24
  s_waitcnt vmcnt(20)
  buffer_load_dwordx4 v10, s[8:11], s23 offen offset:2048 nt lds
  s_add_u32 s28, s28, 1
  s_waitcnt lgkmcnt(0)
  v_readfirstlane_b32 s37, v17
  s_waitcnt vmcnt(20)
  buffer_load_dwordx4 v11, s[8:11], s23 offen offset:3072 nt lds
  s_addk_i32 m0, 0x1000
  s_xor_b32 s23, s22, 0xc800
  s_waitcnt vmcnt(20)
  buffer_load_dwordx4 v8, s[8:11], s23 offen offset:0 nt lds
  s_bfe_u32 s21, s28, 0x40000
  s_lshl_b32 s21, s21, 16
  s_xor_b32 s22, s21, s29
  s_waitcnt vmcnt(20)
  buffer_load_dwordx4 v9, s[8:11], s23 offen offset:1024 nt lds
  s_bfe_u32 s21, s28, 0x10004
  s_lshl_b32 s21, s21, 12
  s_xor_b32 s22, s21, s22
  s_waitcnt vmcnt(20)
  buffer_load_dwordx4 v10, s[8:11], s23 offen offset:2048 nt lds
  s_and_b32 s21, s28, 31
  s_cselect_b32 s37, s37, 5
  s_waitcnt vmcnt(20)
  buffer_load_dwordx4 v11, s[8:11], s23 offen offset:3072 nt lds
  s_mov_b32 m0, s24
  s_mov_b32 s23, s22
  s_cmp_eq_u32 s37, 3
  s_cbranch_scc1 L_load_w3
  s_branch L_load_pick
L_load_w4:
  s_waitcnt vmcnt(22)
  buffer_load_dwordx4 v8, s[8:11], s23 offen offset:0 nt lds
  s_waitcnt vmcnt(22)
  buffer_load_dwordx4 v9, s[8:11], s23 offen offset:1024 nt lds
  s_waitcnt vmcnt(22)
  buffer_load_dwordx4 v10, s[8:11], s23 offen offset:2048 nt lds
  s_waitcnt vmcnt(22)
  buffer_load_dwordx4 v11, s[8:11], s23 offen offset:3072 nt lds
  s_addk_i32 m0, 0x1000
  s_xor_b32 s23, s22, 0x8000
  s_waitcnt vmcnt(22)
  buffer_load_dwordx4 v8, s[8:11], s23 offen offset:0 nt lds
  s_waitcnt vmcnt(22)
  buffer_load_dwordx4 v9, s[8:11], s23 offen offset:1024 nt lds
  s_waitcnt vmcnt(22)
  buffer_load_dwordx4 v10, s[8:11], s23 offen offset:2048 nt lds
  s_waitcnt vmcnt(22)
  buffer_load_dwordx4 v11, s[8:11], s23 offen offset:3072 nt lds
  s_addk_i32 m0, 0x1000
  s_xor_b32 s23, s22, 0x800
  s_waitcnt vmcnt(22)
  buffer_load_dwordx4 v8, s[8:11], s23 offen offset:0 nt lds
  s_waitcnt vmcnt(22)
  buffer_load_dwordx4 v9, s[8:11], s23 offen offset:1024 nt lds
  s_waitcnt vmcnt(22)
  buffer_load_dwordx4 v10, s[8:11], s23 offen offset:2048 nt lds
  s_waitcnt vmcnt(22)
  buffer_load_dwordx4 v11, s[8:11], s23 offen offset:3072 nt lds
  s_addk_i32 m0, 0x1000
  s_xor_b32 s23, s22, 0x8800
  s_waitcnt vmcnt(22)
  buffer_load_dwordx4 v8, s[8:11], s23 offen offset:0 nt lds
  s_waitcnt vmcnt(22)
  buffer_load_dwordx4 v9, s[8:11], s23 offen offset:1024 nt lds
  s_waitcnt vmcnt(22)
  buffer_load_dwordx4 v10, s[8:11], s23 offen offset:2048 nt lds
  s_waitcnt vmcnt(22)
  buffer_load_dwordx4 v11, s[8:11], s23 offen offset:3072 nt lds
  s_addk_i32 m0, 0x1000
  s_xor_b32 s23, s22, 0x4000
  s_waitcnt vmcnt(22)
  buffer_load_dwordx4 v8, s[8:11], s23 offen offset:0 nt lds
  s_waitcnt vmcnt(22)
  buffer_load_dwordx4 v9, s[8:11], s23 offen offset:1024 nt lds
  s_waitcnt vmcnt(22)
  buffer_load_dwordx4 v10, s[8:11], s23 offen offset:2048 nt lds
  s_waitcnt vmcnt(22)
  buffer_load_dwordx4 v11, s[8:11], s23 offen offset:3072 nt lds
  s_addk_i32 m0, 0x1000
  s_xor_b32 s23, s22, 0xc000
  s_waitcnt vmcnt(22)
  buffer_load_dwordx4 v8, s[8:11], s23 offen offset:0 nt lds
  ds_read_b32 v17, v16
  s_waitcnt vmcnt(22)
  buffer_load_dwordx4 v9, s[8:11], s23 offen offset:1024 nt lds
  s_waitcnt vmcnt(22)
  buffer_load_dwordx4 v10, s[8:11], s23 offen offset:2048 nt lds
  s_cmp_eq_u32 s28, 0
  s_waitcnt vmcnt(22)
  buffer_load_dwordx4 v11, s[8:11], s23 offen offset:3072 nt lds
  s_cbranch_scc1 L_load_nobar4
  s_barrier
L_load_nobar4:
  s_addk_i32 m0, 0x1000
  s_xor_b32 s23, s22, 0x4800
  s_waitcnt vmcnt(22)
  buffer_load_dwordx4 v8, s[8:11], s23 offen offset:0 nt lds
  s_waitcnt vmcnt(22)
  buffer_load_dwordx4 v9, s[8:11], s23 offen offset:1024 nt lds
  s_add_u32 s24, m0, 0x2000
  s_cmp_eq_u32 s24, s31
  s_cselect_b32 s24, 0, s24
  s_waitcnt vmcnt(22)
  buffer_load_dwordx4 v10, s[8:11], s23 offen offset:2048 nt lds
  s_add_u32 s28, s28, 1
  s_waitcnt lgkmcnt(0)
  v_readfirstlane_b32 s37, v17
  s_waitcnt vmcnt(22)
  buffer_load_dwordx4 v11, s[8:11], s23 offen offset:3072 nt lds
  s_addk_i32 m0, 0x1000
  s_xor_b32 s23, s22, 0xc800
  s_waitcnt vmcnt(22)
  buffer_load_dwordx4 v8, s[8:11], s23 offen offset:0 nt lds
  s_bfe_u32 s21, s28, 0x40000
  s_lshl_b32 s21, s21, 16
  s_xor_b32 s22, s21, s29
  s_waitcnt vmcnt(22)
  buffer_load_dwordx4 v9, s[8:11], s23 offen offset:1024 nt lds
  s_bfe_u32 s21, s28, 0x10004
  s_lshl_b32 s21, s21, 12
  s_xor_b32 s22, s21, s22
  s_waitcnt vmcnt(22)
  buffer_load_dwordx4 v10, s[8:11], s23 offen offset:2048 nt lds
  s_and_b32 s21, s28, 31
  s_cselect_b32 s37, s37, 5
  s_waitcnt vmcnt(22)
  buffer_load_dwordx4 v11, s[8:11], s23 offen offset:3072 nt lds
  s_mov_b32 m0, s24
  s_mov_b32 s23, s22
  s_cmp_eq_u32 s37, 4
  s_cbranch_scc1 L_load_w4
  s_branch L_load_pick
L_load_phase:
  s_bitcmp1_b32 s28, 6
  s_cbranch_scc1 L_load_done
  v_lshlrev_b32 v4, 1, v2
  v_xor_b32 v4, v4, v3
  v_lshlrev_b32 v4, 4, v4
  v_lshl_add_u32 v8, v2, 8, v4
  v_xor_b32 v9, 0x80, v8
  s_add_u32 s8, s6, s20
  s_addc_u32 s9, s7, 0
  v_xor_b32 v10, 0x1800, v8
  v_xor_b32 v11, 0x1880, v8
  s_branch L_load_loop
L_load_done:
  s_barrier
  s_waitcnt vmcnt(8)
  s_barrier
  s_waitcnt vmcnt(0)
  s_barrier
  s_endpgm
L_monitor:
  s_load_dwordx2 s[34:35], s[0:1], 32
  s_getreg_b32 s38, hwreg(HW_REG_XCC_ID, 0, 3)
  v_mov_b32 v16, 100352
  s_and_b32 s33, s38, 1
  s_mul_i32 s33, s33, -6
  s_add_i32 s33, s33, 1
  s_lshl_b32 s38, s38, 5
  s_add_u32 s39, s39, s38
  v_and_b32 v12, 31, v0
  v_add_u32 v12, s38, v12
  v_mov_b32 v13, s39
  s_mov_b32 s28, 0
  s_waitcnt lgkmcnt(0)
L_mon_loop:
  s_barrier
  s_cmp_eq_u32 s28, 0
  s_cbranch_scc1 L_mon_post
  s_waitcnt vmcnt(0)
  v_cmp_le_u32 vcc, s28, v15
  s_mov_b32 s36, 0
  s_nop 2
  s_bcnt1_i32_b32 s37, vcc_lo
  s_lshl_b32 s37, s37, 1
  s_add_i32 s37, s37, s33
  s_cmp_ge_i32 s37, 10
  s_addc_u32 s36, s36, 0
  s_cmp_ge_i32 s37, 24
  s_addc_u32 s36, s36, 0
  s_cmp_ge_i32 s37, 44
  s_addc_u32 s36, s36, 0
  s_cmp_ge_i32 s37, 56
  s_addc_u32 s36, s36, 0
  v_mov_b32 v17, s36
  ds_write_b32 v16, v17
  s_cmp_eq_u32 s28, 60
  s_cbranch_scc1 L_mon_end
L_mon_post:
  s_add_u32 s28, s28, 1
  v_mov_b32 v14, s28
  s_mov_b64 exec, 1
  global_store_byte v13, v14, s[34:35]
  s_mov_b64 exec, -1
  global_load_ubyte v15, v12, s[34:35] sc1
  s_branch L_mon_loop
L_mon_end:
  s_waitcnt lgkmcnt(0)
  s_endpgm
L_consumer:
  s_cmp_eq_u32 s3, 5
  s_cbranch_scc1 L_monitor
  s_load_dwordx2 s[16:17], s[0:1], 0
  s_load_dwordx2 s[18:19], s[0:1], 24
  v_and_b32 v0, 63, v0
  v_lshlrev_b32 v4, 8, v3
  v_lshl_add_u32 v6, v2, 4, v4
  v_xor_b32 v7, 0x800, v6
  s_lshl_b32 s20, s2, 11
  s_movk_i32 s10, 0x800
  s_lshl_b32 s11, 1, 17
  s_sub_u32 s3, s3, 1
  s_waitcnt lgkmcnt(0)
  s_add_u32 s8, s16, s20
  s_addc_u32 s9, s17, 0
  buffer_load_dwordx4 v[16:19], v6, s[8:11], 0 offen offset:0
  buffer_load_dwordx4 v[20:23], v6, s[8:11], 0 offen offset:64
  buffer_load_dwordx4 v[24:27], v6, s[8:11], 0 offen offset:128
  buffer_load_dwordx4 v[28:31], v6, s[8:11], 0 offen offset:192
  buffer_load_dwordx4 v[32:35], v7, s[8:11], 0 offen offset:0
  buffer_load_dwordx4 v[36:39], v7, s[8:11], 0 offen offset:64
  buffer_load_dwordx4 v[40:43], v7, s[8:11], 0 offen offset:128
  buffer_load_dwordx4 v[44:47], v7, s[8:11], 0 offen offset:192
  s_add_u32 s12, s18, s20
  s_addc_u32 s13, s19, 0
  s_movk_i32 s14, 0x800
  s_lshl_b32 s15, 1, 17
  s_lshl_b32 s24, s3, 13
  v_xor_b32 v5, v2, v3
  v_lshl_add_u32 v5, v5, 4, v4
  v_add_u32 v96, s24, v5
  v_xor_b32 v97, 64, v96
  v_xor_b32 v98, 0x80, v96
  v_xor_b32 v99, 0xc0, v96
  v_mov_b32 v92, 0xff800000
  s_mov_b32 s26, 0
  s_mov_b32 s30, 0
  s_mov_b32 s32, 32768
  s_waitcnt vmcnt(0)
  s_lshl_b32 s20, s2, 20
  s_add_u32 s36, s6, s20
  s_addc_u32 s37, s7, 0
  v_mov_b32 v12, 0
  global_load_dword v12, v12, s[36:37] nt
L_k_loop:
  s_add_u32 s30, s30, s32
  s_cmp_eq_u32 s30, 98304
  s_cselect_b32 s30, 0, s30
  s_cselect_b32 s31, 0xffff0000, s32
  s_barrier
  ds_read_b128 v[48:51], v96 offset:0
  ds_read_b128 v[52:55], v97 offset:0
  ds_read_b128 v[56:59], v98 offset:0
  ds_read_b128 v[60:63], v99 offset:0
  ds_read_b128 v[64:67], v96 offset:4096
  ds_read_b128 v[68:71], v97 offset:4096
  ds_read_b128 v[72:75], v98 offset:4096
  ds_read_b128 v[76:79], v99 offset:4096
  v_add_u32 v96, s31, v96
  v_add_u32 v97, s31, v97
  v_add_u32 v98, s31, v98
  v_add_u32 v99, s31, v99
  s_waitcnt lgkmcnt(7)
  v_mfma_f32_16x16x32_bf16 v[80:83], v[48:51], v[16:19], 0
  s_waitcnt lgkmcnt(6)
  v_mfma_f32_16x16x32_bf16 v[80:83], v[52:55], v[20:23], v[80:83]
  s_waitcnt lgkmcnt(5)
  v_mfma_f32_16x16x32_bf16 v[80:83], v[56:59], v[24:27], v[80:83]
  s_waitcnt lgkmcnt(4)
  v_mfma_f32_16x16x32_bf16 v[80:83], v[60:63], v[28:31], v[80:83]
  s_waitcnt lgkmcnt(3)
  v_mfma_f32_16x16x32_bf16 v[80:83], v[64:67], v[32:35], v[80:83]
  s_waitcnt lgkmcnt(2)
  v_mfma_f32_16x16x32_bf16 v[80:83], v[68:71], v[36:39], v[80:83]
  s_waitcnt lgkmcnt(1)
  v_mfma_f32_16x16x32_bf16 v[80:83], v[72:75], v[40:43], v[80:83]
  s_waitcnt lgkmcnt(0)
  v_mfma_f32_16x16x32_bf16 v[80:83], v[76:79], v[44:47], v[80:83]
  s_nop 7
  s_set_gpr_idx_on s26, gpr_idx(DST)
  v_mov_b32 v120, v80
  v_mov_b32 v121, v81
  v_mov_b32 v122, v82
  v_mov_b32 v123, v83
  s_set_gpr_idx_off
  v_max3_f32 v92, v80, v81, v92
  v_max3_f32 v92, v82, v83, v92
  s_add_u32 s26, s26, 4
  s_cmp_lg_u32 s26, 128
  s_cbranch_scc1 L_k_loop
  v_mov_b32 v95, v92
  s_nop 1
  v_permlane32_swap_b32 v95, v92
  v_max_f32 v92, v95, v92
  v_mov_b32 v95, v92
  s_nop 1
  v_permlane16_swap_b32 v95, v92
  v_max_f32 v92, v95, v92
  s_nop 1
  v_max_f32_dpp v92, v92, v92 row_ror:8 row_mask:0xf bank_mask:0xf
  s_lshl_b32 s27, s3, 8
  s_add_u32 s27, s27, 98304
  v_lshl_add_u32 v8, v0, 2, s27
  ds_write_b32 v8, v92
  v_lshlrev_b32 v9, 2, v0
  v_add_u32 v9, 98304, v9
  v_lshrrev_b32 v5, 2, v0
  v_and_b32 v6, 7, v5
  v_lshlrev_b32 v6, 1, v6
  v_bfe_u32 v7, v0, 1, 1
  v_xor_b32 v6, v6, v7
  v_and_b32 v7, 1, v0
  v_lshlrev_b32 v7, 3, v7
  v_lshl_add_u32 v5, v5, 8, v7
  s_add_u32 s27, s24, s30
  v_add_u32 v5, s27, v5
  v_lshl_add_u32 v100, v6, 4, v5
  v_xor_b32 v101, 32, v100
  v_xor_b32 v102, 64, v100
  v_xor_b32 v103, 96, v100
  v_xor_b32 v104, 128, v100
  v_xor_b32 v105, 160, v100
  v_xor_b32 v106, 192, v100
  v_xor_b32 v107, 224, v100
  v_mov_b64 v[16:17], 0
  v_mov_b64 v[18:19], 0
  v_mov_b64 v[20:21], 0
  v_mov_b64 v[22:23], 0
  v_mov_b64 v[24:25], 0
  v_mov_b64 v[26:27], 0
  v_mov_b64 v[28:29], 0
  v_mov_b64 v[30:31], 0
  v_mov_b64 v[32:33], 0
  v_mov_b64 v[34:35], 0
  v_mov_b64 v[36:37], 0
  v_mov_b64 v[38:39], 0
  v_mov_b64 v[40:41], 0
  v_mov_b64 v[42:43], 0
  v_mov_b64 v[44:45], 0
  v_mov_b64 v[46:47], 0
  v_mov_b32 v93, 0
  s_mov_b32 s25, 0x3e0293ee
  s_mov_b32 s26, 0
  s_add_u32 s30, s30, s32
  s_cmp_eq_u32 s30, 98304
  s_cselect_b32 s30, 0, s30
  s_cselect_b32 s31, 0xffff0000, s32
  s_waitcnt lgkmcnt(0)
  s_barrier
  ds_read2st64_b32 v[88:89], v9 offset0:0 offset1:1
  ds_read2st64_b32 v[90:91], v9 offset0:2 offset1:3
  s_waitcnt lgkmcnt(0)
  v_max3_f32 v92, v88, v89, v90
  v_max_f32 v92, v92, v91
  s_set_gpr_idx_on s26, gpr_idx(SRC0)
  v_sub_f32 v88, v120, v92
  v_sub_f32 v89, v121, v92
  v_sub_f32 v90, v122, v92
  v_sub_f32 v91, v123, v92
  s_set_gpr_idx_off
  v_mul_f32 v88, s25, v88
  v_mul_f32 v89, s25, v89
  v_mul_f32 v90, s25, v90
  v_mul_f32 v91, s25, v91
  v_exp_f32 v88, v88
  v_exp_f32 v89, v89
  v_exp_f32 v90, v90
  v_exp_f32 v91, v91
  s_add_u32 s26, s26, 4
  v_cvt_pk_bf16_f32 v84, v88, v89
  v_cvt_pk_bf16_f32 v85, v90, v91
  v_add_f32 v88, v88, v89
  v_add_f32 v90, v90, v91
  v_mov_b32_dpp v86, v84 row_ror:8 row_mask:0xf bank_mask:0xf
  v_mov_b32_dpp v87, v85 row_ror:8 row_mask:0xf bank_mask:0xf
  v_add_f32 v93, v93, v88
  v_add_f32 v93, v93, v90
  s_branch L_v_entry
L_v_loop:
  s_add_u32 s30, s30, s32
  s_cmp_eq_u32 s30, 98304
  s_cselect_b32 s30, 0, s30
  s_cselect_b32 s31, 0xffff0000, s32
  s_barrier
L_v_entry:
  ds_read_b64_tr_b16 v[48:49], v100 offset:0
  ds_read_b64_tr_b16 v[50:51], v100 offset:4096
  ds_read_b64_tr_b16 v[52:53], v101 offset:0
  ds_read_b64_tr_b16 v[54:55], v101 offset:4096
  ds_read_b64_tr_b16 v[56:57], v102 offset:0
  ds_read_b64_tr_b16 v[58:59], v102 offset:4096
  ds_read_b64_tr_b16 v[60:61], v103 offset:0
  ds_read_b64_tr_b16 v[62:63], v103 offset:4096
  ds_read_b64_tr_b16 v[64:65], v104 offset:0
  ds_read_b64_tr_b16 v[66:67], v104 offset:4096
  ds_read_b64_tr_b16 v[68:69], v105 offset:0
  ds_read_b64_tr_b16 v[70:71], v105 offset:4096
  ds_read_b64_tr_b16 v[72:73], v106 offset:0
  ds_read_b64_tr_b16 v[74:75], v106 offset:4096
  ds_read_b64_tr_b16 v[76:77], v107 offset:0
  ds_read_b64_tr_b16 v[78:79], v107 offset:4096
  v_add_u32 v100, s31, v100
  v_add_u32 v101, s31, v101
  v_add_u32 v102, s31, v102
  v_add_u32 v103, s31, v103
  v_add_u32 v104, s31, v104
  v_add_u32 v105, s31, v105
  v_add_u32 v106, s31, v106
  v_add_u32 v107, s31, v107
  s_waitcnt lgkmcnt(14)
  v_mfma_f32_16x16x32_bf16 v[16:19], v[48:51], v[84:87], v[16:19]
  s_waitcnt lgkmcnt(12)
  v_mfma_f32_16x16x32_bf16 v[20:23], v[52:55], v[84:87], v[20:23]
  s_waitcnt lgkmcnt(10)
  v_mfma_f32_16x16x32_bf16 v[24:27], v[56:59], v[84:87], v[24:27]
  s_waitcnt lgkmcnt(8)
  v_mfma_f32_16x16x32_bf16 v[28:31], v[60:63], v[84:87], v[28:31]
  s_waitcnt lgkmcnt(6)
  v_mfma_f32_16x16x32_bf16 v[32:35], v[64:67], v[84:87], v[32:35]
  s_waitcnt lgkmcnt(4)
  v_mfma_f32_16x16x32_bf16 v[36:39], v[68:71], v[84:87], v[36:39]
  s_waitcnt lgkmcnt(2)
  v_mfma_f32_16x16x32_bf16 v[40:43], v[72:75], v[84:87], v[40:43]
  s_waitcnt lgkmcnt(0)
  v_mfma_f32_16x16x32_bf16 v[44:47], v[76:79], v[84:87], v[44:47]
  s_set_gpr_idx_on s26, gpr_idx(SRC0)
  v_sub_f32 v88, v120, v92
  v_sub_f32 v89, v121, v92
  v_sub_f32 v90, v122, v92
  v_sub_f32 v91, v123, v92
  s_set_gpr_idx_off
  v_mul_f32 v88, s25, v88
  v_mul_f32 v89, s25, v89
  v_mul_f32 v90, s25, v90
  v_mul_f32 v91, s25, v91
  v_exp_f32 v88, v88
  v_exp_f32 v89, v89
  v_exp_f32 v90, v90
  v_exp_f32 v91, v91
  s_add_u32 s26, s26, 4
  v_cvt_pk_bf16_f32 v84, v88, v89
  v_cvt_pk_bf16_f32 v85, v90, v91
  v_add_f32 v88, v88, v89
  v_add_f32 v90, v90, v91
  v_mov_b32_dpp v86, v84 row_ror:8 row_mask:0xf bank_mask:0xf
  v_mov_b32_dpp v87, v85 row_ror:8 row_mask:0xf bank_mask:0xf
  v_add_f32 v93, v93, v88
  v_add_f32 v93, v93, v90
  s_cmp_lg_u32 s26, 128
  s_cbranch_scc1 L_v_loop
  s_lshl_b32 s27, s3, 10
  s_add_u32 s27, s27, 32768
  v_lshl_add_u32 v11, v0, 4, s27
  ds_write_b128 v11, v[84:87] offset:16384
  v_mov_b32 v95, v93
  s_nop 1
  v_permlane32_swap_b32 v95, v93
  v_add_f32 v93, v95, v93
  v_mov_b32 v95, v93
  s_nop 1
  v_permlane16_swap_b32 v95, v93
  v_add_f32 v93, v95, v93
  s_nop 1
  v_add_f32_dpp v93, v93, v93 row_ror:8 row_mask:0xf bank_mask:0xf
  ds_write_b32 v8, v93 offset:1024
  s_lshl_b32 s27, s3, 12
  s_add_u32 s27, s27, 32768
  v_lshl_add_u32 v10, v0, 4, s27
  v_mov_b32_dpp v16, v20 row_ror:8 row_mask:0xf bank_mask:0xc
  v_mov_b32_dpp v17, v21 row_ror:8 row_mask:0xf bank_mask:0xc
  v_mov_b32_dpp v18, v22 row_ror:8 row_mask:0xf bank_mask:0xc
  v_mov_b32_dpp v19, v23 row_ror:8 row_mask:0xf bank_mask:0xc
  ds_write_b128 v10, v[16:19] offset:0
  v_mov_b32_dpp v24, v28 row_ror:8 row_mask:0xf bank_mask:0xc
  v_mov_b32_dpp v25, v29 row_ror:8 row_mask:0xf bank_mask:0xc
  v_mov_b32_dpp v26, v30 row_ror:8 row_mask:0xf bank_mask:0xc
  v_mov_b32_dpp v27, v31 row_ror:8 row_mask:0xf bank_mask:0xc
  ds_write_b128 v10, v[24:27] offset:1024
  v_mov_b32_dpp v32, v36 row_ror:8 row_mask:0xf bank_mask:0xc
  v_mov_b32_dpp v33, v37 row_ror:8 row_mask:0xf bank_mask:0xc
  v_mov_b32_dpp v34, v38 row_ror:8 row_mask:0xf bank_mask:0xc
  v_mov_b32_dpp v35, v39 row_ror:8 row_mask:0xf bank_mask:0xc
  ds_write_b128 v10, v[32:35] offset:2048
  v_mov_b32_dpp v40, v44 row_ror:8 row_mask:0xf bank_mask:0xc
  v_mov_b32_dpp v41, v45 row_ror:8 row_mask:0xf bank_mask:0xc
  v_mov_b32_dpp v42, v46 row_ror:8 row_mask:0xf bank_mask:0xc
  v_mov_b32_dpp v43, v47 row_ror:8 row_mask:0xf bank_mask:0xc
  ds_write_b128 v10, v[40:43] offset:3072
  v_subrev_u32 v4, s24, v100
  s_lshl_b32 s27, s3, 6
  v_xor_b32 v4, s27, v4
  v_xor_b32 v5, 32, v4
  v_lshlrev_b32 v7, 4, v0
  v_add_u32 v7, 49152, v7
  s_waitcnt lgkmcnt(0)
  s_barrier
  ds_read_b128 v[48:51], v11 offset:0
  ds_read_b128 v[52:55], v11 offset:4096
  ds_read_b128 v[56:59], v11 offset:8192
  ds_read_b128 v[60:63], v11 offset:12288
  ds_read2st64_b32 v[16:17], v9 offset0:4 offset1:5
  ds_read2st64_b32 v[18:19], v9 offset0:6 offset1:7
  ds_read_b128 v[104:107], v7 offset:0
  ds_read_b128 v[108:111], v7 offset:1024
  ds_read_b128 v[112:115], v7 offset:2048
  ds_read_b128 v[116:119], v7 offset:3072
  v_and_b32 v6, 7, v3
  v_lshlrev_b32 v6, 8, v6
  v_lshl_add_u32 v6, v2, 3, v6
  v_lshrrev_b32 v10, 3, v3
  v_lshl_add_u32 v6, v10, 5, v6
  s_waitcnt lgkmcnt(4)
  v_add_f32 v48, v48, v52
  v_add_f32 v49, v49, v53
  v_add_f32 v50, v50, v54
  v_add_f32 v51, v51, v55
  v_add_f32 v56, v56, v60
  v_add_f32 v57, v57, v61
  v_add_f32 v58, v58, v62
  v_add_f32 v59, v59, v63
  v_add_f32 v80, v48, v56
  v_add_f32 v81, v49, v57
  v_add_f32 v82, v50, v58
  v_add_f32 v83, v51, v59
  v_add_f32 v16, v16, v17
  v_add_f32 v18, v18, v19
  v_mov_b32_dpp v88, v80 row_ror:8 row_mask:0xf bank_mask:0xf
  v_mov_b32_dpp v89, v81 row_ror:8 row_mask:0xf bank_mask:0xf
  v_mov_b32_dpp v90, v82 row_ror:8 row_mask:0xf bank_mask:0xf
  v_mov_b32_dpp v91, v83 row_ror:8 row_mask:0xf bank_mask:0xf
  v_add_f32 v16, v16, v18
  v_rcp_f32 v93, v16
  s_waitcnt lgkmcnt(0)
  s_barrier
  ds_read_b64_tr_b16 v[48:49], v4 offset:0
  ds_read_b64_tr_b16 v[50:51], v4 offset:4096
  ds_read_b64_tr_b16 v[52:53], v5 offset:0
  ds_read_b64_tr_b16 v[54:55], v5 offset:4096
  ds_read_b64_tr_b16 v[56:57], v4 offset:8192
  ds_read_b64_tr_b16 v[58:59], v4 offset:12288
  ds_read_b64_tr_b16 v[60:61], v5 offset:8192
  ds_read_b64_tr_b16 v[62:63], v5 offset:12288
  ds_read_b64_tr_b16 v[64:65], v4 offset:16384
  ds_read_b64_tr_b16 v[66:67], v4 offset:20480
  ds_read_b64_tr_b16 v[68:69], v5 offset:16384
  ds_read_b64_tr_b16 v[70:71], v5 offset:20480
  s_waitcnt lgkmcnt(10)
  v_mfma_f32_16x16x32_bf16 v[80:83], v[48:51], v[104:107], v[80:83]
  s_waitcnt lgkmcnt(8)
  v_mfma_f32_16x16x32_bf16 v[88:91], v[52:55], v[104:107], v[88:91]
  s_waitcnt lgkmcnt(6)
  v_mfma_f32_16x16x32_bf16 v[80:83], v[56:59], v[108:111], v[80:83]
  s_waitcnt lgkmcnt(4)
  v_mfma_f32_16x16x32_bf16 v[88:91], v[60:63], v[108:111], v[88:91]
  s_waitcnt lgkmcnt(2)
  v_mfma_f32_16x16x32_bf16 v[80:83], v[64:67], v[112:115], v[80:83]
  s_waitcnt lgkmcnt(0)
  v_mfma_f32_16x16x32_bf16 v[88:91], v[68:71], v[112:115], v[88:91]
  s_barrier
  ds_read_b64_tr_b16 v[72:73], v4 offset:24576
  ds_read_b64_tr_b16 v[74:75], v4 offset:28672
  ds_read_b64_tr_b16 v[76:77], v5 offset:24576
  ds_read_b64_tr_b16 v[78:79], v5 offset:28672
  s_waitcnt lgkmcnt(2)
  v_mfma_f32_16x16x32_bf16 v[80:83], v[72:75], v[116:119], v[80:83]
  s_waitcnt lgkmcnt(0)
  v_mfma_f32_16x16x32_bf16 v[88:91], v[76:79], v[116:119], v[88:91]
  s_nop 7
  v_mov_b32_dpp v80, v88 row_ror:8 row_mask:0xf bank_mask:0xc
  v_mov_b32_dpp v81, v89 row_ror:8 row_mask:0xf bank_mask:0xc
  v_mov_b32_dpp v82, v90 row_ror:8 row_mask:0xf bank_mask:0xc
  v_mov_b32_dpp v83, v91 row_ror:8 row_mask:0xf bank_mask:0xc
  v_mul_f32 v80, v80, v93
  v_mul_f32 v81, v81, v93
  v_mul_f32 v82, v82, v93
  v_mul_f32 v83, v83, v93
  v_cvt_pk_bf16_f32 v84, v80, v81
  v_cvt_pk_bf16_f32 v85, v82, v83
  buffer_store_dwordx2 v[84:85], v6, s[12:15], s27 offen
L_end:
  s_endpgm
.section .rodata,"a"
.p2align 6
.amdhsa_kernel standalone__gqa_softmax__sampling_kernel
  .amdhsa_next_free_vgpr 248
  .amdhsa_next_free_sgpr 40
  .amdhsa_accum_offset 248
  .amdhsa_group_segment_fixed_size 0
  .amdhsa_kernarg_size 48
  .amdhsa_user_sgpr_count 2
  .amdhsa_user_sgpr_kernarg_segment_ptr 1
  .amdhsa_system_sgpr_workgroup_id_x 1
.end_amdhsa_kernel
```
